```python
import torch

def _softmax(x, axis=-1):
    return torch.softmax(x, dim=axis)
def _gelu(x):
    return torch.nn.functional.gelu(x, approximate="tanh")
def _silu(x):
    return torch.nn.functional.silu(x)
def _sigmoid(x):
    return torch.sigmoid(x)
def _layernorm(x, axis=-1, eps=1e-5):
    m = x.mean(dim=axis, keepdim=True)
    v = x.var(dim=axis, keepdim=True, unbiased=False)
    return (x - m) / torch.sqrt(v + eps)
def _scatter_add(tgt, idx, src, axis=0):
    return tgt.clone().index_add_(axis, idx, src)
def _segment_sum(src, seg, n):
    out = torch.zeros((n,) + src.shape[1:], dtype=src.dtype)
    return out.index_add_(0, seg, src)
def _pad(x, pw):
    flat = tuple(v for pair in reversed(pw) for v in pair)
    return torch.nn.functional.pad(x, flat)

kernel_name = 'standalone__groupnorm__sampling'

def setup_inputs():

    _w = (lambda a: (lambda t: t.to(torch.bfloat16) if t.is_floating_point() else t)(torch.as_tensor(a)))
    B = 32
    G = 32
    cpg = max(1, 512 // G)
    C = G * cpg
    H, W = 32, 16
    return {
        "x": _w(abs((lambda *s: torch.randn(*s, dtype=torch.bfloat16) * 0.05)(B, C, H, W))),
        "g": _w((lambda *s: torch.randn(*s, dtype=torch.bfloat16) * 0.05)(C) + 1.0),
        "b": _w((lambda *s: torch.randn(*s, dtype=torch.bfloat16) * 0.4)(C)),
    }

def reference(x, g, b):
    G = 32
    B, C, H, W = x.shape[0], x.shape[1], x.shape[2], x.shape[3]
    xr = x.reshape(B, G, C // G, H, W)
    mu = xr.mean(axis=(2, 3, 4), keepdims=True)
    var = ((xr - mu) ** 2).mean(axis=(2, 3, 4), keepdims=True)
    xn = (xr - mu) / torch.sqrt(var + 1e-5)
    xn = xn.reshape(B, C, H, W)
    return xn * g[None, :, None, None] + b[None, :, None, None]
```

```asm
; @launch grid=(1024,1,1) block=(256,1,1) lds=64
.amdgcn_target "amdgcn-amd-amdhsa--gfx950"
.text
.globl standalone__groupnorm__sampling_kernel
.p2align 8
.type standalone__groupnorm__sampling_kernel,@function
standalone__groupnorm__sampling_kernel:
  s_cmp_ge_u32 s2, 0x400
  s_cbranch_scc1 L_end
  s_load_dwordx2 s[12:13], s[0:1], 0
  s_load_dwordx4 s[4:7], s[0:1], 8
  s_load_dwordx2 s[16:17], s[0:1], 24
  v_readfirstlane_b32 s3, v0
  v_and_b32 v1, 63, v0
  v_lshlrev_b32 v1, 4, v1
  s_mov_b32 s14, 0x1000000
  s_mov_b32 s15, 0x20000
  s_mov_b32 s18, 0x1000000
  s_mov_b32 s19, 0x20000
  s_lshl_b32 s20, s2, 14
  s_lshl_b32 s21, s3, 6
  s_add_u32 s20, s20, s21
  s_and_b32 s22, s2, 31
  s_lshl_b32 s22, s22, 5
  s_lshr_b32 s23, s3, 3
  s_add_u32 s22, s22, s23
  s_waitcnt lgkmcnt(0)
  buffer_load_dwordx4 v[4:7], v1, s[12:15], s20 offen nt
  buffer_load_dwordx4 v[8:11], v1, s[12:15], s20 offen offset:1024 nt
  buffer_load_dwordx4 v[12:15], v1, s[12:15], s20 offen offset:2048 nt
  buffer_load_dwordx4 v[16:19], v1, s[12:15], s20 offen offset:3072 nt
  s_load_dwordx2 s[24:25], s[4:5], s22
  s_load_dwordx2 s[26:27], s[6:7], s22
  s_mov_b32 s28, 0x3f803f80
  v_mov_b32 v2, 0
  v_mov_b32 v3, 0
  v_mov_b32 v20, 0
  v_mov_b32 v21, 0
  v_mov_b32 v22, s23
  v_mov_b32 v23, 0
  s_mov_b32 s30, 0
  s_mov_b32 s31, 0x80000000
  s_waitcnt lgkmcnt(0)
  s_lshl_b32 s32, s24, 16
  s_and_b32 s33, s24, 0xffff0000
  s_lshl_b32 s34, s25, 16
  s_and_b32 s35, s25, 0xffff0000
  s_lshl_b32 s36, s26, 16
  s_and_b32 s37, s26, 0xffff0000
  s_lshl_b32 s38, s27, 16
  s_and_b32 s39, s27, 0xffff0000
  s_waitcnt vmcnt(3)
  v_dot2c_f32_bf16 v2, s28, v4
  v_dot2c_f32_bf16 v3, v4, v4
  v_dot2c_f32_bf16 v20, s28, v5
  v_dot2c_f32_bf16 v21, v5, v5
  v_dot2c_f32_bf16 v2, s28, v6
  v_dot2c_f32_bf16 v3, v6, v6
  v_dot2c_f32_bf16 v20, s28, v7
  v_dot2c_f32_bf16 v21, v7, v7
  s_waitcnt vmcnt(2)
  v_dot2c_f32_bf16 v2, s28, v8
  v_dot2c_f32_bf16 v3, v8, v8
  v_dot2c_f32_bf16 v20, s28, v9
  v_dot2c_f32_bf16 v21, v9, v9
  v_dot2c_f32_bf16 v2, s28, v10
  v_dot2c_f32_bf16 v3, v10, v10
  v_dot2c_f32_bf16 v20, s28, v11
  v_dot2c_f32_bf16 v21, v11, v11
  s_waitcnt vmcnt(1)
  v_dot2c_f32_bf16 v2, s28, v12
  v_dot2c_f32_bf16 v3, v12, v12
  v_dot2c_f32_bf16 v20, s28, v13
  v_dot2c_f32_bf16 v21, v13, v13
  v_dot2c_f32_bf16 v2, s28, v14
  v_dot2c_f32_bf16 v3, v14, v14
  v_dot2c_f32_bf16 v20, s28, v15
  v_dot2c_f32_bf16 v21, v15, v15
  s_waitcnt vmcnt(0)
  v_dot2c_f32_bf16 v2, s28, v16
  v_dot2c_f32_bf16 v3, v16, v16
  v_dot2c_f32_bf16 v20, s28, v17
  v_dot2c_f32_bf16 v21, v17, v17
  v_dot2c_f32_bf16 v2, s28, v18
  v_dot2c_f32_bf16 v3, v18, v18
  v_dot2c_f32_bf16 v20, s28, v19
  v_dot2c_f32_bf16 v21, v19, v19
  v_lshlrev_b32 v24, 16, v4
  v_and_b32 v25, 0xffff0000, v4
  v_lshlrev_b32 v26, 16, v5
  v_add_f32 v2, v2, v20
  v_add_f32 v3, v3, v21
  v_readfirstlane_b32 s29, v2
  v_mul_f32 v20, 0x3d000000, v2
  v_fma_f32 v3, -v20, v2, v3
  v_subrev_f32 v2, s29, v2
  v_mul_f32 v20, 0x3d000000, v2
  v_fmac_f32 v3, v20, v2
  v_and_b32 v27, 0xffff0000, v5
  v_lshlrev_b32 v28, 16, v6
  v_permlane32_swap_b32 v2, v3
  v_add_f32 v2, v2, v3
  v_and_b32 v29, 0xffff0000, v6
  v_lshlrev_b32 v30, 16, v7
  v_add_f32_dpp v2, v2, v2 quad_perm:[1,0,3,2] row_mask:0xf bank_mask:0xf
  v_and_b32 v31, 0xffff0000, v7
  v_lshlrev_b32 v32, 16, v8
  v_add_f32_dpp v2, v2, v2 quad_perm:[2,3,0,1] row_mask:0xf bank_mask:0xf
  v_and_b32 v33, 0xffff0000, v8
  v_lshlrev_b32 v34, 16, v9
  v_add_f32_dpp v2, v2, v2 row_half_mirror row_mask:0xf bank_mask:0xf
  v_and_b32 v35, 0xffff0000, v9
  v_lshlrev_b32 v36, 16, v10
  v_add_f32_dpp v2, v2, v2 row_mirror row_mask:0xf bank_mask:0xf
  v_and_b32 v37, 0xffff0000, v10
  v_lshlrev_b32 v38, 16, v11
  v_add_f32_dpp v2, v2, v2 row_bcast:15 row_mask:0xa bank_mask:0xf
  v_and_b32 v39, 0xffff0000, v11
  v_lshlrev_b32 v40, 16, v12
  v_mov_b32_dpp v20, v2 row_bcast:31 row_mask:0xc bank_mask:0xf
  v_mov_b32 v21, 0x42800000
  v_mul_f32 v3, 0x3a000000, v20
  v_fma_f32 v3, -v3, v20, v2
  v_fma_f32 v2, s29, v21, v20
  s_mov_b64 exec, s[30:31]
  ds_write_b64 v22, v[2:3]
  s_mov_b64 exec, -1
  s_waitcnt lgkmcnt(0)
  s_barrier
  ds_read_b128 v[56:59], v23
  ds_read_b128 v[60:63], v23 offset:16
  v_and_b32 v41, 0xffff0000, v12
  v_lshlrev_b32 v42, 16, v13
  v_and_b32 v43, 0xffff0000, v13
  v_lshlrev_b32 v44, 16, v14
  v_and_b32 v45, 0xffff0000, v14
  v_lshlrev_b32 v46, 16, v15
  v_and_b32 v47, 0xffff0000, v15
  v_lshlrev_b32 v48, 16, v16
  v_and_b32 v49, 0xffff0000, v16
  v_lshlrev_b32 v50, 16, v17
  v_and_b32 v51, 0xffff0000, v17
  v_lshlrev_b32 v52, 16, v18
  v_and_b32 v53, 0xffff0000, v18
  v_lshlrev_b32 v54, 16, v19
  v_and_b32 v55, 0xffff0000, v19
  s_waitcnt lgkmcnt(0)
  v_pk_add_f32 v[2:3], v[56:57], v[58:59]
  v_pk_add_f32 v[20:21], v[60:61], v[62:63]
  v_pk_add_f32 v[2:3], v[2:3], v[20:21]
  v_mul_f32 v20, 0x3e800000, v2
  v_sub_f32 v56, v56, v20
  v_sub_f32 v58, v58, v20
  v_sub_f32 v60, v60, v20
  v_sub_f32 v62, v62, v20
  v_mul_f32 v21, v56, v56
  v_mul_f32 v22, v60, v60
  v_fmac_f32 v21, v58, v58
  v_fmac_f32 v22, v62, v62
  v_mul_f32 v2, 0x39000000, v2
  v_add_f32 v21, v21, v22
  v_fmac_f32 v3, 0x3a000000, v21
  v_mul_f32 v3, 0x39000000, v3
  v_cvt_pk_bf16_f32 v20, 0, v2
  v_sub_f32 v21, v2, v20
  v_fmac_f32 v3, v21, v21
  v_cvt_pk_bf16_f32 v3, 0, v3
  v_add_f32 v3, 0x3727c5ac, v3
  v_cvt_pk_bf16_f32 v3, 0, v3
  v_sqrt_f32 v3, v3
  s_nop 0
  v_cvt_pk_bf16_f32 v3, 0, v3
  v_rcp_f32 v3, v3
  s_nop 0
  v_mul_f32 v56, s32, v3
  v_mul_f32 v58, s33, v3
  v_mul_f32 v60, s34, v3
  v_mul_f32 v62, s35, v3
  v_fma_f32 v57, -v20, v56, s36
  v_fma_f32 v59, -v20, v58, s37
  v_fma_f32 v61, -v20, v60, s38
  v_fma_f32 v63, -v20, v62, s39
  v_pk_fma_f32 v[24:25], v[24:25], v[56:57], v[56:57] op_sel:[0,0,1] op_sel_hi:[1,0,1]
  v_pk_fma_f32 v[26:27], v[26:27], v[56:57], v[56:57] op_sel:[0,0,1] op_sel_hi:[1,0,1]
  v_pk_fma_f32 v[28:29], v[28:29], v[56:57], v[56:57] op_sel:[0,0,1] op_sel_hi:[1,0,1]
  v_pk_fma_f32 v[30:31], v[30:31], v[56:57], v[56:57] op_sel:[0,0,1] op_sel_hi:[1,0,1]
  v_cvt_pk_bf16_f32 v4, v24, v25
  v_cvt_pk_bf16_f32 v5, v26, v27
  v_cvt_pk_bf16_f32 v6, v28, v29
  v_cvt_pk_bf16_f32 v7, v30, v31
  buffer_store_dwordx4 v[4:7], v1, s[16:19], s20 offen nt
  v_pk_fma_f32 v[32:33], v[32:33], v[58:59], v[58:59] op_sel:[0,0,1] op_sel_hi:[1,0,1]
  v_pk_fma_f32 v[34:35], v[34:35], v[58:59], v[58:59] op_sel:[0,0,1] op_sel_hi:[1,0,1]
  v_pk_fma_f32 v[36:37], v[36:37], v[58:59], v[58:59] op_sel:[0,0,1] op_sel_hi:[1,0,1]
  v_pk_fma_f32 v[38:39], v[38:39], v[58:59], v[58:59] op_sel:[0,0,1] op_sel_hi:[1,0,1]
  v_cvt_pk_bf16_f32 v8, v32, v33
  v_cvt_pk_bf16_f32 v9, v34, v35
  v_cvt_pk_bf16_f32 v10, v36, v37
  v_cvt_pk_bf16_f32 v11, v38, v39
  buffer_store_dwordx4 v[8:11], v1, s[16:19], s20 offen offset:1024 nt
  v_pk_fma_f32 v[40:41], v[40:41], v[60:61], v[60:61] op_sel:[0,0,1] op_sel_hi:[1,0,1]
  v_pk_fma_f32 v[42:43], v[42:43], v[60:61], v[60:61] op_sel:[0,0,1] op_sel_hi:[1,0,1]
  v_pk_fma_f32 v[44:45], v[44:45], v[60:61], v[60:61] op_sel:[0,0,1] op_sel_hi:[1,0,1]
  v_pk_fma_f32 v[46:47], v[46:47], v[60:61], v[60:61] op_sel:[0,0,1] op_sel_hi:[1,0,1]
  v_cvt_pk_bf16_f32 v12, v40, v41
  v_cvt_pk_bf16_f32 v13, v42, v43
  v_cvt_pk_bf16_f32 v14, v44, v45
  v_cvt_pk_bf16_f32 v15, v46, v47
  buffer_store_dwordx4 v[12:15], v1, s[16:19], s20 offen offset:2048 nt
  v_pk_fma_f32 v[48:49], v[48:49], v[62:63], v[62:63] op_sel:[0,0,1] op_sel_hi:[1,0,1]
  v_pk_fma_f32 v[50:51], v[50:51], v[62:63], v[62:63] op_sel:[0,0,1] op_sel_hi:[1,0,1]
  v_pk_fma_f32 v[52:53], v[52:53], v[62:63], v[62:63] op_sel:[0,0,1] op_sel_hi:[1,0,1]
  v_pk_fma_f32 v[54:55], v[54:55], v[62:63], v[62:63] op_sel:[0,0,1] op_sel_hi:[1,0,1]
  v_cvt_pk_bf16_f32 v16, v48, v49
  v_cvt_pk_bf16_f32 v17, v50, v51
  v_cvt_pk_bf16_f32 v18, v52, v53
  v_cvt_pk_bf16_f32 v19, v54, v55
  buffer_store_dwordx4 v[16:19], v1, s[16:19], s20 offen offset:3072 nt
L_end:
  s_endpgm
.section .rodata,"a"
.p2align 6
.amdhsa_kernel standalone__groupnorm__sampling_kernel
  .amdhsa_next_free_vgpr 64
  .amdhsa_next_free_sgpr 40
  .amdhsa_accum_offset 64
  .amdhsa_group_segment_fixed_size 0
  .amdhsa_kernarg_size 48
  .amdhsa_user_sgpr_count 2
  .amdhsa_user_sgpr_kernarg_segment_ptr 1
  .amdhsa_system_sgpr_workgroup_id_x 1
.end_amdhsa_kernel
```
